```python
import torch

def _softmax(x, axis=-1):
    return torch.softmax(x, dim=axis)
def _gelu(x):
    return torch.nn.functional.gelu(x, approximate="tanh")
def _silu(x):
    return torch.nn.functional.silu(x)
def _sigmoid(x):
    return torch.sigmoid(x)
def _layernorm(x, axis=-1, eps=1e-5):
    m = x.mean(dim=axis, keepdim=True)
    v = x.var(dim=axis, keepdim=True, unbiased=False)
    return (x - m) / torch.sqrt(v + eps)
def _scatter_add(tgt, idx, src, axis=0):
    return tgt.clone().index_add_(axis, idx, src)
def _segment_sum(src, seg, n):
    out = torch.zeros((n,) + src.shape[1:], dtype=src.dtype)
    return out.index_add_(0, seg, src)
def _pad(x, pw):
    flat = tuple(v for pair in reversed(pw) for v in pair)
    return torch.nn.functional.pad(x, flat)

kernel_name = 'standalone__swiglu_ffn__sampling'

def setup_inputs():

    _w = (lambda a: (lambda t: t.to(torch.bfloat16) if t.is_floating_point() else t)(torch.as_tensor(a)))
    B, S, D, F = 16, 4, 1024, 3584
    return {
        "x": _w((lambda *s: torch.randn(*s, dtype=torch.bfloat16) * 0.05)(B, S, D)),
        "w_gate": _w((lambda *s: torch.randn(*s, dtype=torch.bfloat16) * 0.05)(D, F)),
        "w_up": _w((lambda *s: torch.randn(*s, dtype=torch.bfloat16) * 0.05)(D, F)),
        "w_down": _w((lambda *s: torch.randn(*s, dtype=torch.bfloat16) * 0.05)(F, D)),
    }

def reference(x, w_gate, w_up, w_down):
    g = _silu(x @ w_gate)
    u = x @ w_up
    return (g * u) @ w_down
```

```asm
; @launch grid=(256,1,1) block=(512,1,1) lds=163840
.amdgcn_target "amdgcn-amd-amdhsa--gfx950"
.text
.globl standalone__swiglu_ffn__sampling_kernel
.p2align 8
.type standalone__swiglu_ffn__sampling_kernel,@function
standalone__swiglu_ffn__sampling_kernel:
    s_load_dwordx8 s[4:11], s[0:1], 0
    v_lshrrev_b32 v1, 6, v0
    v_and_b32 v0, 63, v0
    s_lshr_b32 s20, s2, 3
    v_readfirstlane_b32 s18, v1
    s_cmp_ge_u32 s20, 32
    s_cbranch_scc1 L_end
    s_and_b32 s19, s2, 7
    s_lshl_b32 s31, 1, 17
    s_lshl_b32 s30, 7, 20
    s_cmp_lt_u32 s18, 4
    s_cbranch_scc1 L_compute
    s_cmp_ge_u32 s20, 18
    s_cbranch_scc1 L_worker_loader
    s_cmp_lg_u32 s18, 4
    s_cbranch_scc1 L_helper_idle
    s_cmp_lg_u32 s20, 17
    s_cbranch_scc1 L_nocode
    s_getpc_b64 s[56:57]
L_pc:
    v_lshlrev_b32 v24, 7, v0
    global_load_dword v25, v24, s[56:57] offset:192
L_nocode:
    v_mul_u32_u24 v14, 37, v0
    v_lshrrev_b32 v14, 8, v14
    v_mad_u32_u24 v14, v14, 49, v0
    v_lshlrev_b32 v14, 7, v14
    s_lshr_b32 s54, s20, 1
    s_lshl_b32 s54, s54, 6
    s_add_u32 s54, s54, s19
    s_mulk_i32 s54, 896
    v_lshlrev_b32 v9, 11, v0
    s_lshl_b32 s44, s20, 7
    s_mov_b32 s26, s31
    s_mov_b32 s27, s31
    s_waitcnt lgkmcnt(0)
    s_mov_b64 s[24:25], s[4:5]
    buffer_load_dword v15, v9, s[24:27], s44 offen
    s_bitcmp1_b32 s20, 0
    s_cselect_b64 s[28:29], s[8:9], s[6:7]
    s_bfm_b64 exec, 56, 0
L_pf:
    buffer_load_dword v15, v14, s[28:31], s54 offen
L_pf2:
    s_add_u32 s54, s54, 516096
    s_cmp_lt_u32 s54, s30
    s_cbranch_scc1 L_pf
    s_mov_b64 exec, -1
L_helper_idle:
    s_and_b32 s47, s18, 3
    s_waitcnt lgkmcnt(0)
    s_branch L_helper_wd
L_worker_loader:
    s_and_b32 s47, s18, 3
    s_load_dwordx4 s[12:15], s[0:1], 40
    s_sub_u32 s41, s20, 18
    v_lshrrev_b32 v1, 3, v0
    v_and_b32 v2, 7, v0
    v_lshrrev_b32 v3, 4, v0
    s_and_b32 s3, s47, 1
    s_lshl_b32 s45, s3, 6
    v_xor_b32 v4, v2, v3
    v_lshlrev_b32 v4, 4, v4
    v_lshl_add_u32 v8, v1, 11, v4
    v_xor_b32 v8, s45, v8
    s_lshl_b32 s42, s47, 14
    s_and_b32 s43, s41, 1
    s_lshl_b32 s44, s43, 16
    s_add_u32 s3, s44, s42
    v_add_u32 v8, s3, v8
    s_lshr_b32 s40, s41, 1
    s_lshl_b32 s51, s47, 10
    s_mov_b32 s26, s31
    s_mov_b32 s27, s31
    s_cmp_lg_u32 s2, 145
    s_waitcnt lgkmcnt(0)
    s_cbranch_scc1 L_epubdone
    s_lshl_b32 s3, 3, 20
    v_mov_b32 v11, s3
    s_load_dword s3, s[14:15], s3 glc
    v_mov_b32 v10, 0
    s_mov_b64 exec, 1
    s_cmp_lg_u32 s18, 4
    s_waitcnt lgkmcnt(0)
    s_cbranch_scc1 L_epubwait
    s_add_u32 s3, s3, 2
    s_or_b32 s3, s3, 1
    v_mov_b32 v15, s3
    global_store_dword v10, v15, s[12:13] sc1
    global_store_dword v11, v15, s[14:15] sc1
L_epubwait:
    s_mov_b64 exec, -1
L_epubdone:
    s_mul_i32 s3, s19, 7
    s_add_u32 s3, s3, s40
    s_lshl_b32 s3, s3, 7
    s_mul_i32 s48, s47, 57344
    s_add_u32 s3, s3, s48
    v_and_b32 v4, 1, v3
    v_lshlrev_b32 v4, 5, v4
    v_lshlrev_b32 v5, 4, v2
    v_bitop3_b32 v4, v4, v5, s45 bitop3:0x96
    v_mul_u32_u24 v6, 7168, v1
    v_add3_u32 v12, v6, v4, s3
    v_add_u32 v13, 228352, v12
    s_lshl_b32 s50, s47, 11
    s_mov_b32 s38, s30
    s_mov_b32 s39, s31
    s_mov_b32 s24, s4
    s_and_b32 s25, s5, 0xffff
    s_add_u32 m0, s51, 131072
    s_movk_i32 s53, 0
    buffer_load_dwordx4 v8, s[24:27], s53 offen lds
    s_add_u32 m0, s51, 135168
    s_movk_i32 s53, 128
    buffer_load_dwordx4 v8, s[24:27], s53 offen lds
    s_add_u32 m0, s51, 139264
    s_movk_i32 s53, 256
    buffer_load_dwordx4 v8, s[24:27], s53 offen lds
    s_mov_b32 s28, s6
    s_and_b32 s29, s7, 0xffff
    s_mov_b32 s36, s8
    s_and_b32 s37, s9, 0xffff
    s_add_u32 m0, s50, 0
    s_nop 0
    buffer_load_dwordx4 v12, s[28:31], 0 offen lds
    buffer_load_dwordx4 v13, s[28:31], 0 offen offset:1024 lds
    s_add_u32 m0, s50, 8192
    s_nop 0
    buffer_load_dwordx4 v12, s[36:39], 0 offen lds
    buffer_load_dwordx4 v13, s[36:39], 0 offen offset:1024 lds
    s_add_u32 m0, s51, 143360
    s_movk_i32 s53, 384
    buffer_load_dwordx4 v8, s[24:27], s53 offen lds
    s_mov_b32 s53, 458752
    s_add_u32 m0, s50, 16384
    s_nop 0
    buffer_load_dwordx4 v12, s[28:31], s53 offen lds
    buffer_load_dwordx4 v13, s[28:31], s53 offen offset:1024 lds
    s_add_u32 m0, s50, 24576
    s_nop 0
    buffer_load_dwordx4 v12, s[36:39], s53 offen lds
    buffer_load_dwordx4 v13, s[36:39], s53 offen offset:1024 lds
    s_add_u32 m0, s51, 147456
    s_movk_i32 s53, 512
    buffer_load_dwordx4 v8, s[24:27], s53 offen lds
    s_mov_b32 s53, 917504
    s_add_u32 m0, s50, 32768
    s_nop 0
    buffer_load_dwordx4 v12, s[28:31], s53 offen lds
    buffer_load_dwordx4 v13, s[28:31], s53 offen offset:1024 lds
    s_add_u32 m0, s50, 40960
    s_nop 0
    buffer_load_dwordx4 v12, s[36:39], s53 offen lds
    buffer_load_dwordx4 v13, s[36:39], s53 offen offset:1024 lds
    s_add_u32 m0, s51, 151552
    s_movk_i32 s53, 640
    buffer_load_dwordx4 v8, s[24:27], s53 offen lds
    s_mov_b32 s23, s20
    s_cmp_lt_u32 s20, 16
    s_cbranch_scc1 L_strip1
    s_and_b32 s3, s20, 1
    s_lshl_b32 s3, s3, 3
    s_add_u32 s23, s3, 3
    s_cmp_lt_u32 s20, 18
    s_cbranch_scc1 L_strip1
    s_sub_u32 s3, s20, 18
    s_cmp_ge_u32 s3, 3
    s_addc_u32 s23, s3, 0
    s_cmp_ge_u32 s3, 10
    s_addc_u32 s23, s23, 0
L_strip1:
    v_lshrrev_b32 v1, 3, v0
    v_and_b32 v2, 7, v0
    v_lshrrev_b32 v3, 4, v0
    v_lshlrev_b32 v4, 5, v3
    v_lshlrev_b32 v5, 4, v2
    v_xor_b32 v4, v4, v5
    v_lshl_add_u32 v20, v1, 11, v4
    s_mul_i32 s3, s19, 917504
    s_lshl_b32 s52, s47, 14
    s_add_u32 s52, s52, s3
    s_lshl_b32 s3, s23, 7
    s_add_u32 s52, s52, s3
    v_add_u32 v20, s52, v20
    v_add_u32 v21, 458752, v20
    s_lshl_b32 s51, s47, 10
    s_mov_b32 s32, s10
    s_and_b32 s33, s11, 0xffff
    s_mov_b32 s34, 0x700000
    s_mov_b32 s35, 0x00020000
    s_mul_i32 s3, s23, 37
    s_lshr_b32 s3, s3, 8
    s_mul_i32 s3, s3, 7
    s_sub_u32 s3, s23, s3
    s_lshl_b32 s4, s3, 16
    s_add_u32 s3, s3, 1
    s_cmp_eq_u32 s3, 7
    s_cselect_b32 s3, 0, s3
    s_lshl_b32 s5, s3, 16
    s_add_u32 s3, s3, 1
    s_cmp_eq_u32 s3, 7
    s_cselect_b32 s3, 0, s3
    s_lshl_b32 s6, s3, 16
    s_add_u32 s3, s3, 1
    s_cmp_eq_u32 s3, 7
    s_cselect_b32 s3, 0, s3
    s_lshl_b32 s7, s3, 16
    s_add_u32 s3, s3, 1
    s_cmp_eq_u32 s3, 7
    s_cselect_b32 s3, 0, s3
    s_lshl_b32 s8, s3, 16
    s_add_u32 s3, s3, 1
    s_cmp_eq_u32 s3, 7
    s_cselect_b32 s3, 0, s3
    s_lshl_b32 s9, s3, 16
    s_add_u32 s3, s3, 1
    s_cmp_eq_u32 s3, 7
    s_cselect_b32 s3, 0, s3
    s_lshl_b32 s10, s3, 16
    s_waitcnt vmcnt(11)
    s_barrier
    s_mov_b32 s53, 1376256
    s_add_u32 m0, s50, 49152
    s_nop 0
    buffer_load_dwordx4 v12, s[28:31], s53 offen lds
    buffer_load_dwordx4 v13, s[28:31], s53 offen offset:1024 lds
    s_add_u32 m0, s50, 57344
    s_nop 0
    buffer_load_dwordx4 v12, s[36:39], s53 offen lds
    buffer_load_dwordx4 v13, s[36:39], s53 offen offset:1024 lds
    s_add_u32 m0, s51, 155648
    s_movk_i32 s53, 768
    buffer_load_dwordx4 v8, s[24:27], s53 offen lds
    s_waitcnt vmcnt(11)
    s_barrier
    s_mov_b32 s53, 1835008
    s_add_u32 m0, s50, 65536
    s_nop 0
    buffer_load_dwordx4 v12, s[28:31], s53 offen lds
    buffer_load_dwordx4 v13, s[28:31], s53 offen offset:1024 lds
    s_add_u32 m0, s50, 73728
    s_nop 0
    buffer_load_dwordx4 v12, s[36:39], s53 offen lds
    buffer_load_dwordx4 v13, s[36:39], s53 offen offset:1024 lds
    s_add_u32 m0, s51, 159744
    s_movk_i32 s53, 896
    buffer_load_dwordx4 v8, s[24:27], s53 offen lds
    s_waitcnt vmcnt(11)
    s_barrier
    s_mov_b32 s53, 2293760
    s_add_u32 m0, s50, 81920
    s_nop 0
    buffer_load_dwordx4 v12, s[28:31], s53 offen lds
    buffer_load_dwordx4 v13, s[28:31], s53 offen offset:1024 lds
    s_add_u32 m0, s50, 90112
    s_nop 0
    buffer_load_dwordx4 v12, s[36:39], s53 offen lds
    buffer_load_dwordx4 v13, s[36:39], s53 offen offset:1024 lds
    s_add_u32 m0, s51, 131072
    s_movk_i32 s53, 1024
    buffer_load_dwordx4 v8, s[24:27], s53 offen lds
    s_waitcnt vmcnt(11)
    s_barrier
    s_mov_b32 s53, 2752512
    s_add_u32 m0, s50, 98304
    s_nop 0
    buffer_load_dwordx4 v12, s[28:31], s53 offen lds
    buffer_load_dwordx4 v13, s[28:31], s53 offen offset:1024 lds
    s_add_u32 m0, s50, 106496
    s_nop 0
    buffer_load_dwordx4 v12, s[36:39], s53 offen lds
    buffer_load_dwordx4 v13, s[36:39], s53 offen offset:1024 lds
    s_add_u32 m0, s51, 135168
    s_movk_i32 s53, 1152
    buffer_load_dwordx4 v8, s[24:27], s53 offen lds
    s_waitcnt vmcnt(11)
    s_barrier
    s_mov_b32 s53, 3211264
    s_add_u32 m0, s50, 114688
    s_nop 0
    buffer_load_dwordx4 v12, s[28:31], s53 offen lds
    buffer_load_dwordx4 v13, s[28:31], s53 offen offset:1024 lds
    s_add_u32 m0, s50, 122880
    s_nop 0
    buffer_load_dwordx4 v12, s[36:39], s53 offen lds
    buffer_load_dwordx4 v13, s[36:39], s53 offen offset:1024 lds
    s_add_u32 m0, s51, 139264
    s_movk_i32 s53, 1280
    buffer_load_dwordx4 v8, s[24:27], s53 offen lds
    s_waitcnt vmcnt(11)
    s_barrier
    s_mov_b32 s53, 3670016
    s_add_u32 m0, s50, 0
    s_nop 0
    buffer_load_dwordx4 v12, s[28:31], s53 offen lds
    buffer_load_dwordx4 v13, s[28:31], s53 offen offset:1024 lds
    s_add_u32 m0, s50, 8192
    s_nop 0
    buffer_load_dwordx4 v12, s[36:39], s53 offen lds
    buffer_load_dwordx4 v13, s[36:39], s53 offen offset:1024 lds
    s_add_u32 m0, s51, 143360
    s_movk_i32 s53, 1408
    buffer_load_dwordx4 v8, s[24:27], s53 offen lds
    s_waitcnt vmcnt(11)
    s_barrier
    s_mov_b32 s53, 4128768
    s_add_u32 m0, s50, 16384
    s_nop 0
    buffer_load_dwordx4 v12, s[28:31], s53 offen lds
    buffer_load_dwordx4 v13, s[28:31], s53 offen offset:1024 lds
    s_add_u32 m0, s50, 24576
    s_nop 0
    buffer_load_dwordx4 v12, s[36:39], s53 offen lds
    buffer_load_dwordx4 v13, s[36:39], s53 offen offset:1024 lds
    s_add_u32 m0, s51, 147456
    s_movk_i32 s53, 1536
    buffer_load_dwordx4 v8, s[24:27], s53 offen lds
    s_waitcnt vmcnt(11)
    s_barrier
    s_mov_b32 s53, 4587520
    s_add_u32 m0, s50, 32768
    s_nop 0
    buffer_load_dwordx4 v12, s[28:31], s53 offen lds
    buffer_load_dwordx4 v13, s[28:31], s53 offen offset:1024 lds
    s_add_u32 m0, s50, 40960
    s_nop 0
    buffer_load_dwordx4 v12, s[36:39], s53 offen lds
    buffer_load_dwordx4 v13, s[36:39], s53 offen offset:1024 lds
    s_add_u32 m0, s51, 151552
    s_movk_i32 s53, 1664
    buffer_load_dwordx4 v8, s[24:27], s53 offen lds
    s_waitcnt vmcnt(11)
    s_barrier
    s_mov_b32 s53, 5046272
    s_add_u32 m0, s50, 49152
    s_nop 0
    buffer_load_dwordx4 v12, s[28:31], s53 offen lds
    buffer_load_dwordx4 v13, s[28:31], s53 offen offset:1024 lds
    s_add_u32 m0, s50, 57344
    s_nop 0
    buffer_load_dwordx4 v12, s[36:39], s53 offen lds
    buffer_load_dwordx4 v13, s[36:39], s53 offen offset:1024 lds
    s_add_u32 m0, s51, 155648
    s_movk_i32 s53, 1792
    buffer_load_dwordx4 v8, s[24:27], s53 offen lds
    s_waitcnt vmcnt(11)
    s_barrier
    s_mov_b32 s53, 5505024
    s_add_u32 m0, s50, 65536
    s_nop 0
    buffer_load_dwordx4 v12, s[28:31], s53 offen lds
    buffer_load_dwordx4 v13, s[28:31], s53 offen offset:1024 lds
    s_add_u32 m0, s50, 73728
    s_nop 0
    buffer_load_dwordx4 v12, s[36:39], s53 offen lds
    buffer_load_dwordx4 v13, s[36:39], s53 offen offset:1024 lds
    s_add_u32 m0, s51, 159744
    s_movk_i32 s53, 1920
    buffer_load_dwordx4 v8, s[24:27], s53 offen lds
    s_waitcnt vmcnt(11)
    s_barrier
    s_mov_b32 s53, 5963776
    s_add_u32 m0, s50, 81920
    s_nop 0
    buffer_load_dwordx4 v12, s[28:31], s53 offen lds
    buffer_load_dwordx4 v13, s[28:31], s53 offen offset:1024 lds
    s_add_u32 m0, s50, 90112
    s_nop 0
    buffer_load_dwordx4 v12, s[36:39], s53 offen lds
    buffer_load_dwordx4 v13, s[36:39], s53 offen offset:1024 lds
    s_waitcnt vmcnt(10)
    s_barrier
    s_mov_b32 s53, 6422528
    s_add_u32 m0, s50, 98304
    s_nop 0
    buffer_load_dwordx4 v12, s[28:31], s53 offen lds
    buffer_load_dwordx4 v13, s[28:31], s53 offen offset:1024 lds
    s_add_u32 m0, s50, 106496
    s_nop 0
    buffer_load_dwordx4 v12, s[36:39], s53 offen lds
    buffer_load_dwordx4 v13, s[36:39], s53 offen offset:1024 lds
    s_mov_b32 s53, 6881280
    s_add_u32 m0, s50, 114688
    s_nop 0
    buffer_load_dwordx4 v12, s[28:31], s53 offen lds
    buffer_load_dwordx4 v13, s[28:31], s53 offen offset:1024 lds
    s_add_u32 m0, s50, 122880
    s_nop 0
    buffer_load_dwordx4 v12, s[36:39], s53 offen lds
    buffer_load_dwordx4 v13, s[36:39], s53 offen offset:1024 lds
    s_waitcnt vmcnt(13)
    s_barrier
    s_waitcnt vmcnt(8)
    s_barrier
    s_waitcnt vmcnt(4)
    s_barrier
    s_add_u32 m0, s51, 0
    s_nop 0
    buffer_load_dwordx4 v20, s[32:35], s4 offen lds
    s_add_u32 m0, s51, 28672
    s_nop 0
    buffer_load_dwordx4 v21, s[32:35], s4 offen lds
    s_add_u32 m0, s51, 4096
    s_nop 0
    buffer_load_dwordx4 v20, s[32:35], s5 offen lds
    s_add_u32 m0, s51, 32768
    s_nop 0
    buffer_load_dwordx4 v21, s[32:35], s5 offen lds
    s_waitcnt vmcnt(4)
    s_barrier
    s_add_u32 m0, s51, 8192
    s_nop 0
    buffer_load_dwordx4 v20, s[32:35], s6 offen lds
    s_add_u32 m0, s51, 36864
    s_nop 0
    buffer_load_dwordx4 v21, s[32:35], s6 offen lds
    s_add_u32 m0, s51, 12288
    s_nop 0
    buffer_load_dwordx4 v20, s[32:35], s7 offen lds
    s_add_u32 m0, s51, 40960
    s_nop 0
    buffer_load_dwordx4 v21, s[32:35], s7 offen lds
    s_add_u32 m0, s51, 16384
    s_nop 0
    buffer_load_dwordx4 v20, s[32:35], s8 offen lds
    s_add_u32 m0, s51, 45056
    s_nop 0
    buffer_load_dwordx4 v21, s[32:35], s8 offen lds
    s_add_u32 m0, s51, 20480
    s_nop 0
    buffer_load_dwordx4 v20, s[32:35], s9 offen lds
    s_add_u32 m0, s51, 49152
    s_nop 0
    buffer_load_dwordx4 v21, s[32:35], s9 offen lds
    s_add_u32 m0, s51, 24576
    s_nop 0
    buffer_load_dwordx4 v20, s[32:35], s10 offen lds
    s_add_u32 m0, s51, 53248
    s_nop 0
    buffer_load_dwordx4 v21, s[32:35], s10 offen lds
    s_waitcnt vmcnt(0)
    s_barrier
    s_branch L_ldexit
L_helper_wd:
    s_mov_b32 s23, s20
    s_cmp_lt_u32 s20, 16
    s_cbranch_scc1 L_strip2
    s_and_b32 s3, s20, 1
    s_lshl_b32 s3, s3, 3
    s_add_u32 s23, s3, 3
    s_cmp_lt_u32 s20, 18
    s_cbranch_scc1 L_strip2
    s_sub_u32 s3, s20, 18
    s_cmp_ge_u32 s3, 3
    s_addc_u32 s23, s3, 0
    s_cmp_ge_u32 s3, 10
    s_addc_u32 s23, s23, 0
L_strip2:
    v_lshrrev_b32 v1, 3, v0
    v_and_b32 v2, 7, v0
    v_lshrrev_b32 v3, 4, v0
    v_lshlrev_b32 v4, 5, v3
    v_lshlrev_b32 v5, 4, v2
    v_xor_b32 v4, v4, v5
    v_lshl_add_u32 v20, v1, 11, v4
    s_mul_i32 s3, s19, 917504
    s_lshl_b32 s52, s47, 14
    s_add_u32 s52, s52, s3
    s_lshl_b32 s3, s23, 7
    s_add_u32 s52, s52, s3
    v_add_u32 v20, s52, v20
    v_add_u32 v21, 458752, v20
    s_lshl_b32 s51, s47, 10
    s_mov_b32 s32, s10
    s_and_b32 s33, s11, 0xffff
    s_mov_b32 s34, 0x700000
    s_mov_b32 s35, 0x00020000
    s_mul_i32 s3, s23, 37
    s_lshr_b32 s3, s3, 8
    s_mul_i32 s3, s3, 7
    s_sub_u32 s3, s23, s3
    s_lshl_b32 s4, s3, 16
    s_add_u32 s3, s3, 1
    s_cmp_eq_u32 s3, 7
    s_cselect_b32 s3, 0, s3
    s_lshl_b32 s5, s3, 16
    s_add_u32 s3, s3, 1
    s_cmp_eq_u32 s3, 7
    s_cselect_b32 s3, 0, s3
    s_lshl_b32 s6, s3, 16
    s_add_u32 s3, s3, 1
    s_cmp_eq_u32 s3, 7
    s_cselect_b32 s3, 0, s3
    s_lshl_b32 s7, s3, 16
    s_add_u32 s3, s3, 1
    s_cmp_eq_u32 s3, 7
    s_cselect_b32 s3, 0, s3
    s_lshl_b32 s8, s3, 16
    s_add_u32 s3, s3, 1
    s_cmp_eq_u32 s3, 7
    s_cselect_b32 s3, 0, s3
    s_lshl_b32 s9, s3, 16
    s_add_u32 s3, s3, 1
    s_cmp_eq_u32 s3, 7
    s_cselect_b32 s3, 0, s3
    s_lshl_b32 s10, s3, 16
    s_barrier
    s_cmp_ge_u32 s20, 16
    s_cbranch_scc1 L_wd2
L_wd1:
    s_add_u32 m0, s51, 0
    s_nop 0
    buffer_load_dwordx4 v20, s[32:35], s4 offen lds
    s_add_u32 m0, s51, 28672
    s_nop 0
    buffer_load_dwordx4 v21, s[32:35], s4 offen lds
    s_add_u32 m0, s51, 4096
    s_nop 0
    buffer_load_dwordx4 v20, s[32:35], s5 offen lds
    s_add_u32 m0, s51, 32768
    s_nop 0
    buffer_load_dwordx4 v21, s[32:35], s5 offen lds
    s_add_u32 m0, s51, 8192
    s_nop 0
    buffer_load_dwordx4 v20, s[32:35], s6 offen lds
    s_add_u32 m0, s51, 36864
    s_nop 0
    buffer_load_dwordx4 v21, s[32:35], s6 offen lds
    s_add_u32 m0, s51, 12288
    s_nop 0
    buffer_load_dwordx4 v20, s[32:35], s7 offen lds
    s_cmp_ge_u32 s20, 16
    s_cbranch_scc1 L_wdwait
L_wd2:
    s_add_u32 m0, s51, 40960
    s_nop 0
    buffer_load_dwordx4 v21, s[32:35], s7 offen lds
    s_add_u32 m0, s51, 16384
    s_nop 0
    buffer_load_dwordx4 v20, s[32:35], s8 offen lds
    s_add_u32 m0, s51, 45056
    s_nop 0
    buffer_load_dwordx4 v21, s[32:35], s8 offen lds
    s_add_u32 m0, s51, 20480
    s_nop 0
    buffer_load_dwordx4 v20, s[32:35], s9 offen lds
    s_add_u32 m0, s51, 49152
    s_nop 0
    buffer_load_dwordx4 v21, s[32:35], s9 offen lds
    s_add_u32 m0, s51, 24576
    s_nop 0
    buffer_load_dwordx4 v20, s[32:35], s10 offen lds
    s_add_u32 m0, s51, 53248
    s_nop 0
    buffer_load_dwordx4 v21, s[32:35], s10 offen lds
    s_cmp_ge_u32 s20, 16
    s_cbranch_scc1 L_wd1
L_wdwait:
    s_waitcnt vmcnt(0)
L_predone:
    s_barrier
L_ldexit:
    s_endpgm
L_compute:
    s_load_dwordx4 s[12:15], s[0:1], 32
    s_load_dwordx2 s[16:17], s[0:1], 48
    s_and_b32 s21, s18, 1
    s_lshr_b32 s22, s18, 1
    v_and_b32 v1, 15, v0
    v_lshrrev_b32 v2, 4, v0
    v_lshrrev_b32 v3, 2, v1
    v_and_b32 v4, 3, v0
    v_lshlrev_b32 v16, 4, v0
    v_lshlrev_b32 v17, 2, v0
    s_cmp_ge_u32 s20, 16
    s_cselect_b32 s41, 1, 0
    s_mov_b32 s23, s20
    s_cmp_lt_u32 s20, 16
    s_cbranch_scc1 L_strip3
    s_and_b32 s3, s20, 1
    s_lshl_b32 s3, s3, 3
    s_add_u32 s23, s3, 3
    s_cmp_lt_u32 s20, 18
    s_cbranch_scc1 L_strip3
    s_sub_u32 s3, s20, 18
    s_cmp_ge_u32 s3, 3
    s_addc_u32 s23, s3, 0
    s_cmp_ge_u32 s3, 10
    s_addc_u32 s23, s23, 0
L_strip3:
    s_lshl_b32 s3, s22, 1
    v_lshl_add_u32 v5, v2, 2, v3
    v_lshrrev_b32 v6, 1, v5
    v_and_b32 v6, 3, v6
    v_xor_b32 v6, s3, v6
    v_lshlrev_b32 v5, 7, v5
    v_lshl_add_u32 v5, v4, 3, v5
    v_lshl_add_u32 v12, v6, 5, v5
    s_mul_i32 s3, s22, 28672
    v_add_u32 v12, s3, v12
    v_xor_b32 v13, 32, v12
    v_xor_b32 v14, 64, v12
    v_xor_b32 v15, 96, v12
    s_lshl_b32 s3, s19, 1
    s_add_u32 s3, s3, s41
    s_lshl_b32 s63, s3, 5
    s_add_u32 s63, s63, s23
    s_lshl_b32 s63, s63, 2
    s_add_u32 s63, s63, 0xa0000
    s_lshl_b32 s3, s3, 1
    s_add_u32 s3, s3, s21
    s_lshl_b32 s3, s3, 1
    s_add_u32 s3, s3, s22
    s_mul_i32 s48, s3, 7168
    s_lshr_b32 s3, s48, 2
    s_add_u32 s60, s3, 0x80000
    s_lshl_b32 s3, s18, 11
    s_add_u32 s3, s3, 57344
    v_add_u32 v232, s3, v16
    s_xor_b32 s42, s18, 2
    s_lshl_b32 s3, s42, 11
    s_add_u32 s3, s3, 57344
    v_add_u32 v233, s3, v16
    v_mov_b32 v234, 0xff
    s_lshl_b32 s42, s41, 4
    s_add_u32 s42, s42, s23
    s_lshl_b32 s3, s42, 1
    s_add_u32 s3, s3, s21
    s_lshl_b32 s3, s3, 5
    s_add_u32 s3, s3, s19
    s_lshl_b32 s3, s3, 1
    s_add_u32 s3, s3, s22
    s_lshl_b32 s3, s3, 9
    s_add_u32 s53, s3, 0x100000
    v_lshlrev_b32 v237, 13, v3
    v_lshl_add_u32 v237, v2, 6, v237
    v_lshl_add_u32 v237, v4, 4, v237
    s_lshl_b32 s3, s42, 3
    s_add_u32 s3, s3, s19
    s_lshl_b32 s3, s3, 13
    s_add_u32 s61, s3, 0x100000
    s_add_u32 s62, s61, 4096
    s_lshl_b32 s3, s41, 3
    s_add_u32 s3, s3, s19
    s_lshl_b32 s3, s3, 13
    s_lshl_b32 s55, s23, 7
    s_add_u32 s55, s55, s3
    v_lshlrev_b32 v238, 10, v2
    v_lshl_add_u32 v238, v1, 4, v238
    s_lshl_b32 s3, s18, 8
    v_add_u32 v238, s3, v238
    v_lshlrev_b32 v235, 11, v4
    v_lshl_add_u32 v235, v3, 3, v235
    v_lshl_add_u32 v235, v2, 1, v235
    s_lshl_b32 s3, s18, 5
    v_add_u32 v235, s3, v235
    s_lshl_b32 s3, s19, 1
    s_and_b32 s37, s20, 1
    s_add_u32 s3, s3, s37
    s_lshl_b32 s3, s3, 7
    s_add_u32 s49, s3, 0xa0000
    s_cmp_eq_u32 s18, 1
    s_cselect_b32 s49, s49, 0
    s_cmp_ge_u32 s20, 18
    s_cselect_b32 s49, s49, 0
    s_mov_b32 s52, 0xffff0000
    s_mov_b32 s36, 0xffff
    s_mov_b32 s38, 0xbfb8aa3b
    s_mov_b32 s39, 0xbfb8aa3b
    s_mov_b32 s26, 0x300000
    s_mov_b32 s27, 0x00020000
    s_mov_b32 s30, 256
    s_waitcnt lgkmcnt(0)
    s_mov_b32 s24, s16
    s_and_b32 s25, s17, 0xffff
    s_mov_b32 s28, s14
    s_and_b32 s29, s15, 0xffff
    s_mov_b32 s32, s12
    s_and_b32 s33, s13, 0xffff
    s_mov_b32 s34, 0x20000
    s_mov_b32 s35, 0x00020000
    s_mul_i32 s3, s23, 37
    s_lshr_b32 s3, s3, 8
    s_mul_i32 s3, s3, 7
    s_sub_u32 s3, s23, s3
    s_lshl_b32 s37, s3, 10
    s_add_u32 s4, s37, s48
    s_lshl_b32 s37, s3, 8
    s_add_u32 s11, s37, s60
    s_add_u32 s3, s3, 1
    s_cmp_eq_u32 s3, 7
    s_cselect_b32 s3, 0, s3
    s_lshl_b32 s37, s3, 10
    s_add_u32 s5, s37, s48
    s_lshl_b32 s37, s3, 8
    s_add_u32 s12, s37, s60
    s_add_u32 s3, s3, 1
    s_cmp_eq_u32 s3, 7
    s_cselect_b32 s3, 0, s3
    s_lshl_b32 s37, s3, 10
    s_add_u32 s6, s37, s48
    s_lshl_b32 s37, s3, 8
    s_add_u32 s13, s37, s60
    s_add_u32 s3, s3, 1
    s_cmp_eq_u32 s3, 7
    s_cselect_b32 s3, 0, s3
    s_lshl_b32 s37, s3, 10
    s_add_u32 s7, s37, s48
    s_lshl_b32 s37, s3, 8
    s_add_u32 s14, s37, s60
    s_add_u32 s3, s3, 1
    s_cmp_eq_u32 s3, 7
    s_cselect_b32 s3, 0, s3
    s_lshl_b32 s37, s3, 10
    s_add_u32 s8, s37, s48
    s_lshl_b32 s37, s3, 8
    s_add_u32 s15, s37, s60
    s_add_u32 s3, s3, 1
    s_cmp_eq_u32 s3, 7
    s_cselect_b32 s3, 0, s3
    s_lshl_b32 s37, s3, 10
    s_add_u32 s9, s37, s48
    s_lshl_b32 s37, s3, 8
    s_add_u32 s50, s37, s60
    s_add_u32 s3, s3, 1
    s_cmp_eq_u32 s3, 7
    s_cselect_b32 s3, 0, s3
    s_lshl_b32 s37, s3, 10
    s_add_u32 s10, s37, s48
    s_lshl_b32 s37, s3, 8
    s_add_u32 s51, s37, s60
    s_cmp_lt_u32 s20, 18
    s_cbranch_scc1 L_helper_compute
    v_lshrrev_b32 v5, 1, v1
    v_xor_b32 v5, v5, v2
    v_lshlrev_b32 v5, 4, v5
    v_lshl_add_u32 v8, v1, 7, v5
    s_lshl_b32 s3, s21, 11
    s_add_u32 s3, s3, 131072
    v_add_u32 v8, s3, v8
    v_xor_b32 v9, 64, v8
    v_lshlrev_b32 v5, 11, v2
    v_lshl_add_u32 v5, v3, 7, v5
    v_lshl_add_u32 v5, v4, 3, v5
    v_and_b32 v6, 1, v2
    v_lshlrev_b32 v6, 1, v6
    v_lshrrev_b32 v7, 1, v3
    v_or_b32 v6, v6, v7
    s_lshl_b32 s3, s22, 1
    v_xor_b32 v6, s3, v6
    v_lshl_add_u32 v10, v6, 5, v5
    v_xor_b32 v11, 32, v10
    s_sub_u32 s40, s20, 18
    s_and_b32 s3, s40, 1
    s_lshl_b32 s44, s19, 1
    s_add_u32 s44, s44, s3
    s_lshl_b32 s44, s44, 1
    s_add_u32 s44, s44, s21
    s_mul_i32 s44, s44, 14
    s_andn2_b32 s3, s40, 1
    s_add_u32 s44, s44, s3
    s_add_u32 s44, s44, s22
    s_lshl_b32 s45, s44, 8
    s_add_u32 s45, s45, 0x80000
    s_lshl_b32 s44, s44, 10
    v_mov_b32 v24, 0
    v_mov_b32 v25, 0
    v_mov_b32 v26, 0
    v_mov_b32 v27, 0
    v_mov_b32 v28, 0
    v_mov_b32 v29, 0
    v_mov_b32 v30, 0
    v_mov_b32 v31, 0
    v_mov_b32 v32, 0
    v_mov_b32 v33, 0
    v_mov_b32 v34, 0
    v_mov_b32 v35, 0
    v_mov_b32 v36, 0
    v_mov_b32 v37, 0
    v_mov_b32 v38, 0
    v_mov_b32 v39, 0
    v_mov_b32 v80, 0
    v_mov_b32 v81, 0
    v_mov_b32 v82, 0
    v_mov_b32 v83, 0
    v_mov_b32 v84, 0
    v_mov_b32 v85, 0
    v_mov_b32 v86, 0
    v_mov_b32 v87, 0
    v_mov_b32 v88, 0
    v_mov_b32 v89, 0
    v_mov_b32 v90, 0
    v_mov_b32 v91, 0
    v_mov_b32 v92, 0
    v_mov_b32 v93, 0
    v_mov_b32 v94, 0
    v_mov_b32 v95, 0
    v_mov_b32 v96, 0
    v_mov_b32 v97, 0
    v_mov_b32 v98, 0
    v_mov_b32 v99, 0
    v_mov_b32 v100, 0
    v_mov_b32 v101, 0
    v_mov_b32 v102, 0
    v_mov_b32 v103, 0
    v_mov_b32 v104, 0
    v_mov_b32 v105, 0
    v_mov_b32 v106, 0
    v_mov_b32 v107, 0
    v_mov_b32 v108, 0
    v_mov_b32 v109, 0
    v_mov_b32 v110, 0
    v_mov_b32 v111, 0
    v_mov_b32 v112, 0
    v_mov_b32 v113, 0
    v_mov_b32 v114, 0
    v_mov_b32 v115, 0
    v_mov_b32 v116, 0
    v_mov_b32 v117, 0
    v_mov_b32 v118, 0
    v_mov_b32 v119, 0
    s_mov_b32 s40, 0
L_c1:
    s_barrier
    s_waitcnt lgkmcnt(9)
    ds_read_b128 v[40:43], v8 offset:0
    v_mfma_f32_16x16x32_bf16 v[24:27], v[84:87], v[80:83], v[24:27]
    ds_read_b64_tr_b16 v[44:45], v10 offset:0
    ds_read_b64_tr_b16 v[46:47], v10 offset:512
    v_mfma_f32_16x16x32_bf16 v[28:31], v[88:91], v[80:83], v[28:31]
    ds_read_b64_tr_b16 v[48:49], v11 offset:0
    ds_read_b64_tr_b16 v[50:51], v11 offset:512
    v_mfma_f32_16x16x32_bf16 v[32:35], v[92:95], v[80:83], v[32:35]
    ds_read_b64_tr_b16 v[52:53], v10 offset:8192
    ds_read_b64_tr_b16 v[54:55], v10 offset:8704
    v_mfma_f32_16x16x32_bf16 v[36:39], v[96:99], v[80:83], v[36:39]
    ds_read_b64_tr_b16 v[56:57], v11 offset:8192
    ds_read_b64_tr_b16 v[58:59], v11 offset:8704
    s_waitcnt lgkmcnt(9)
    ds_read_b128 v[60:63], v9 offset:0
    v_mfma_f32_16x16x32_bf16 v[24:27], v[104:107], v[100:103], v[24:27]
    ds_read_b64_tr_b16 v[64:65], v10 offset:1024
    ds_read_b64_tr_b16 v[66:67], v10 offset:1536
    v_mfma_f32_16x16x32_bf16 v[28:31], v[108:111], v[100:103], v[28:31]
    ds_read_b64_tr_b16 v[68:69], v11 offset:1024
    ds_read_b64_tr_b16 v[70:71], v11 offset:1536
    v_mfma_f32_16x16x32_bf16 v[32:35], v[112:115], v[100:103], v[32:35]
    ds_read_b64_tr_b16 v[72:73], v10 offset:9216
    ds_read_b64_tr_b16 v[74:75], v10 offset:9728
    v_mfma_f32_16x16x32_bf16 v[36:39], v[116:119], v[100:103], v[36:39]
    ds_read_b64_tr_b16 v[76:77], v11 offset:9216
    ds_read_b64_tr_b16 v[78:79], v11 offset:9728
    s_barrier
    s_waitcnt lgkmcnt(9)
    ds_read_b128 v[80:83], v8 offset:4096
    v_mfma_f32_16x16x32_bf16 v[24:27], v[44:47], v[40:43], v[24:27]
    ds_read_b64_tr_b16 v[84:85], v10 offset:16384
    ds_read_b64_tr_b16 v[86:87], v10 offset:16896
    v_mfma_f32_16x16x32_bf16 v[28:31], v[48:51], v[40:43], v[28:31]
    ds_read_b64_tr_b16 v[88:89], v11 offset:16384
    ds_read_b64_tr_b16 v[90:91], v11 offset:16896
    v_mfma_f32_16x16x32_bf16 v[32:35], v[52:55], v[40:43], v[32:35]
    ds_read_b64_tr_b16 v[92:93], v10 offset:24576
    ds_read_b64_tr_b16 v[94:95], v10 offset:25088
    v_mfma_f32_16x16x32_bf16 v[36:39], v[56:59], v[40:43], v[36:39]
    ds_read_b64_tr_b16 v[96:97], v11 offset:24576
    ds_read_b64_tr_b16 v[98:99], v11 offset:25088
    s_waitcnt lgkmcnt(9)
    ds_read_b128 v[100:103], v9 offset:4096
    v_mfma_f32_16x16x32_bf16 v[24:27], v[64:67], v[60:63], v[24:27]
    ds_read_b64_tr_b16 v[104:105], v10 offset:17408
    ds_read_b64_tr_b16 v[106:107], v10 offset:17920
    v_mfma_f32_16x16x32_bf16 v[28:31], v[68:71], v[60:63], v[28:31]
    ds_read_b64_tr_b16 v[108:109], v11 offset:17408
    ds_read_b64_tr_b16 v[110:111], v11 offset:17920
    v_mfma_f32_16x16x32_bf16 v[32:35], v[72:75], v[60:63], v[32:35]
    ds_read_b64_tr_b16 v[112:113], v10 offset:25600
    ds_read_b64_tr_b16 v[114:115], v10 offset:26112
    v_mfma_f32_16x16x32_bf16 v[36:39], v[76:79], v[60:63], v[36:39]
    ds_read_b64_tr_b16 v[116:117], v11 offset:25600
    ds_read_b64_tr_b16 v[118:119], v11 offset:26112
    s_barrier
    s_cmp_lg_u32 s40, 3
    s_cbranch_scc1 L_notag
    s_mov_b64 exec, 1
    buffer_load_dword v18, v17, s[28:31], 0 offen sc1
    s_mov_b64 exec, -1
L_notag:
    s_waitcnt lgkmcnt(9)
    ds_read_b128 v[40:43], v8 offset:8192
    v_mfma_f32_16x16x32_bf16 v[24:27], v[84:87], v[80:83], v[24:27]
    ds_read_b64_tr_b16 v[44:45], v10 offset:32768
    ds_read_b64_tr_b16 v[46:47], v10 offset:33280
    v_mfma_f32_16x16x32_bf16 v[28:31], v[88:91], v[80:83], v[28:31]
    ds_read_b64_tr_b16 v[48:49], v11 offset:32768
    ds_read_b64_tr_b16 v[50:51], v11 offset:33280
    v_mfma_f32_16x16x32_bf16 v[32:35], v[92:95], v[80:83], v[32:35]
    ds_read_b64_tr_b16 v[52:53], v10 offset:40960
    ds_read_b64_tr_b16 v[54:55], v10 offset:41472
    v_mfma_f32_16x16x32_bf16 v[36:39], v[96:99], v[80:83], v[36:39]
    ds_read_b64_tr_b16 v[56:57], v11 offset:40960
    ds_read_b64_tr_b16 v[58:59], v11 offset:41472
    s_waitcnt lgkmcnt(9)
    ds_read_b128 v[60:63], v9 offset:8192
    v_mfma_f32_16x16x32_bf16 v[24:27], v[104:107], v[100:103], v[24:27]
    ds_read_b64_tr_b16 v[64:65], v10 offset:33792
    ds_read_b64_tr_b16 v[66:67], v10 offset:34304
    v_mfma_f32_16x16x32_bf16 v[28:31], v[108:111], v[100:103], v[28:31]
    ds_read_b64_tr_b16 v[68:69], v11 offset:33792
    ds_read_b64_tr_b16 v[70:71], v11 offset:34304
    v_mfma_f32_16x16x32_bf16 v[32:35], v[112:115], v[100:103], v[32:35]
    ds_read_b64_tr_b16 v[72:73], v10 offset:41984
    ds_read_b64_tr_b16 v[74:75], v10 offset:42496
    v_mfma_f32_16x16x32_bf16 v[36:39], v[116:119], v[100:103], v[36:39]
    ds_read_b64_tr_b16 v[76:77], v11 offset:41984
    ds_read_b64_tr_b16 v[78:79], v11 offset:42496
    s_barrier
    s_waitcnt lgkmcnt(9)
    ds_read_b128 v[80:83], v8 offset:12288
    v_mfma_f32_16x16x32_bf16 v[24:27], v[44:47], v[40:43], v[24:27]
    ds_read_b64_tr_b16 v[84:85], v10 offset:49152
    ds_read_b64_tr_b16 v[86:87], v10 offset:49664
    v_mfma_f32_16x16x32_bf16 v[28:31], v[48:51], v[40:43], v[28:31]
    ds_read_b64_tr_b16 v[88:89], v11 offset:49152
    ds_read_b64_tr_b16 v[90:91], v11 offset:49664
    v_mfma_f32_16x16x32_bf16 v[32:35], v[52:55], v[40:43], v[32:35]
    ds_read_b64_tr_b16 v[92:93], v10 offset:57344
    ds_read_b64_tr_b16 v[94:95], v10 offset:57856
    v_mfma_f32_16x16x32_bf16 v[36:39], v[56:59], v[40:43], v[36:39]
    ds_read_b64_tr_b16 v[96:97], v11 offset:57344
    ds_read_b64_tr_b16 v[98:99], v11 offset:57856
    s_waitcnt lgkmcnt(9)
    ds_read_b128 v[100:103], v9 offset:12288
    v_mfma_f32_16x16x32_bf16 v[24:27], v[64:67], v[60:63], v[24:27]
    ds_read_b64_tr_b16 v[104:105], v10 offset:50176
    ds_read_b64_tr_b16 v[106:107], v10 offset:50688
    v_mfma_f32_16x16x32_bf16 v[28:31], v[68:71], v[60:63], v[28:31]
    ds_read_b64_tr_b16 v[108:109], v11 offset:50176
    ds_read_b64_tr_b16 v[110:111], v11 offset:50688
    v_mfma_f32_16x16x32_bf16 v[32:35], v[72:75], v[60:63], v[32:35]
    ds_read_b64_tr_b16 v[112:113], v10 offset:58368
    ds_read_b64_tr_b16 v[114:115], v10 offset:58880
    v_mfma_f32_16x16x32_bf16 v[36:39], v[76:79], v[60:63], v[36:39]
    ds_read_b64_tr_b16 v[116:117], v11 offset:58368
    ds_read_b64_tr_b16 v[118:119], v11 offset:58880
    v_xor_b32 v8, 0x4000, v8
    v_xor_b32 v9, 0x4000, v9
    v_xor_b32 v10, 0x10000, v10
    v_xor_b32 v11, 0x10000, v11
    s_add_u32 s40, s40, 1
    s_cmp_lt_u32 s40, 4
    s_cbranch_scc1 L_c1
    s_waitcnt vmcnt(0)
    v_readfirstlane_b32 s46, v18
    s_cmp_eq_u32 s46, 0
    s_cbranch_scc1 L_tagslowW
L_tagokW:
    s_mul_i32 s46, s46, 0x9e3779b1
    s_waitcnt lgkmcnt(9)
    v_mfma_f32_16x16x32_bf16 v[24:27], v[84:87], v[80:83], v[24:27]
    v_mfma_f32_16x16x32_bf16 v[28:31], v[88:91], v[80:83], v[28:31]
    v_mfma_f32_16x16x32_bf16 v[32:35], v[92:95], v[80:83], v[32:35]
    v_mfma_f32_16x16x32_bf16 v[36:39], v[96:99], v[80:83], v[36:39]
    s_waitcnt lgkmcnt(0)
    v_mfma_f32_16x16x32_bf16 v[24:27], v[104:107], v[100:103], v[24:27]
    v_mfma_f32_16x16x32_bf16 v[28:31], v[108:111], v[100:103], v[28:31]
    v_mfma_f32_16x16x32_bf16 v[32:35], v[112:115], v[100:103], v[32:35]
    v_mfma_f32_16x16x32_bf16 v[36:39], v[116:119], v[100:103], v[36:39]
    s_and_b32 s56, s46, 0xff
    s_bfe_u32 s57, s46, 0x80008
    s_bfe_u32 s58, s46, 0x80010
    s_lshr_b32 s59, s46, 24
    s_nop 1
    v_cvt_pk_bf16_f32 v40, v24, v25
    v_cvt_pk_bf16_f32 v41, v26, v27
    v_cvt_pk_bf16_f32 v42, v28, v29
    v_cvt_pk_bf16_f32 v43, v30, v31
    v_lshlrev_b32 v24, 16, v40
    v_and_b32 v25, s52, v40
    v_lshlrev_b32 v26, 16, v41
    v_and_b32 v27, s52, v41
    v_lshlrev_b32 v28, 16, v42
    v_and_b32 v29, s52, v42
    v_lshlrev_b32 v30, 16, v43
    v_and_b32 v31, s52, v43
    v_pk_mul_f32 v[40:41], v[24:25], s[38:39]
    v_pk_mul_f32 v[42:43], v[26:27], s[38:39]
    v_pk_mul_f32 v[44:45], v[28:29], s[38:39]
    v_pk_mul_f32 v[46:47], v[30:31], s[38:39]
    v_exp_f32 v40, v40
    v_exp_f32 v41, v41
    v_exp_f32 v42, v42
    v_exp_f32 v43, v43
    v_exp_f32 v44, v44
    v_exp_f32 v45, v45
    v_exp_f32 v46, v46
    v_exp_f32 v47, v47
    v_cvt_pk_bf16_f32 v48, v32, v33
    v_cvt_pk_bf16_f32 v49, v34, v35
    v_cvt_pk_bf16_f32 v50, v36, v37
    v_cvt_pk_bf16_f32 v51, v38, v39
    v_pk_add_f32 v[40:41], v[40:41], 1.0 op_sel_hi:[1,0]
    v_pk_add_f32 v[42:43], v[42:43], 1.0 op_sel_hi:[1,0]
    v_pk_add_f32 v[44:45], v[44:45], 1.0 op_sel_hi:[1,0]
    v_pk_add_f32 v[46:47], v[46:47], 1.0 op_sel_hi:[1,0]
    v_rcp_f32 v40, v40
    v_rcp_f32 v41, v41
    v_rcp_f32 v42, v42
    v_rcp_f32 v43, v43
    v_rcp_f32 v44, v44
    v_rcp_f32 v45, v45
    v_rcp_f32 v46, v46
    v_rcp_f32 v47, v47
    v_and_b32 v32, s36, v48
    v_and_b32 v33, s52, v48
    v_and_b32 v34, s36, v49
    v_and_b32 v35, s52, v49
    v_and_b32 v36, s36, v50
    v_and_b32 v37, s52, v50
    v_and_b32 v38, s36, v51
    v_and_b32 v39, s52, v51
    v_pk_mul_f32 v[24:25], v[24:25], v[40:41]
    v_pk_mul_f32 v[26:27], v[26:27], v[42:43]
    v_pk_mul_f32 v[28:29], v[28:29], v[44:45]
    v_pk_mul_f32 v[30:31], v[30:31], v[46:47]
    v_cvt_pk_bf16_f32 v40, v24, v25
    v_cvt_pk_bf16_f32 v41, v26, v27
    v_cvt_pk_bf16_f32 v42, v28, v29
    v_cvt_pk_bf16_f32 v43, v30, v31
    v_dot2_f32_bf16 v24, v40, v32, 0
    v_dot2_f32_bf16 v25, v40, v33, 0
    v_dot2_f32_bf16 v26, v41, v34, 0
    v_dot2_f32_bf16 v27, v41, v35, 0
    v_dot2_f32_bf16 v28, v42, v36, 0
    v_dot2_f32_bf16 v29, v42, v37, 0
    v_dot2_f32_bf16 v30, v43, v38, 0
    v_dot2_f32_bf16 v31, v43, v39, 0
    s_nop 0
    v_cvt_pk_bf16_f32 v228, v24, v25
    v_cvt_pk_bf16_f32 v229, v26, v27
    v_cvt_pk_bf16_f32 v230, v28, v29
    v_cvt_pk_bf16_f32 v231, v30, v31
    buffer_store_dwordx4 v[228:231], v16, s[24:27], s44 offen
    v_alignbit_b32 v236, v230, v230, 7
    v_bitop3_b32 v236, v228, v229, v236 bitop3:0x96
    v_bitop3_b32 v236, v236, v231, s46 bitop3:0x96
    buffer_store_dword v236, v17, s[24:27], s45 offen
L_join:
    s_barrier
L_ph2:
    ds_read_b64_tr_b16 v[104:105], v14 offset:0
    ds_read_b64_tr_b16 v[106:107], v14 offset:2048
    ds_read_b64_tr_b16 v[108:109], v15 offset:0
    ds_read_b64_tr_b16 v[110:111], v15 offset:2048
    ds_read_b64_tr_b16 v[96:97], v12 offset:0
    ds_read_b64_tr_b16 v[98:99], v12 offset:2048
    ds_read_b64_tr_b16 v[100:101], v13 offset:0
    ds_read_b64_tr_b16 v[102:103], v13 offset:2048
    buffer_load_dwordx4 v[32:35], v16, s[24:27], s4 offen sc1
    buffer_load_dword v60, v17, s[24:27], s11 offen sc1
    ds_read_b64_tr_b16 v[120:121], v14 offset:4096
    ds_read_b64_tr_b16 v[122:123], v14 offset:6144
    ds_read_b64_tr_b16 v[124:125], v15 offset:4096
    ds_read_b64_tr_b16 v[126:127], v15 offset:6144
    ds_read_b64_tr_b16 v[112:113], v12 offset:4096
    ds_read_b64_tr_b16 v[114:115], v12 offset:6144
    ds_read_b64_tr_b16 v[116:117], v13 offset:4096
    ds_read_b64_tr_b16 v[118:119], v13 offset:6144
    buffer_load_dwordx4 v[36:39], v16, s[24:27], s5 offen sc1
    buffer_load_dword v61, v17, s[24:27], s12 offen sc1
    ds_read_b64_tr_b16 v[136:137], v14 offset:8192
    ds_read_b64_tr_b16 v[138:139], v14 offset:10240
    ds_read_b64_tr_b16 v[140:141], v15 offset:8192
    ds_read_b64_tr_b16 v[142:143], v15 offset:10240
    ds_read_b64_tr_b16 v[128:129], v12 offset:8192
    ds_read_b64_tr_b16 v[130:131], v12 offset:10240
    ds_read_b64_tr_b16 v[132:133], v13 offset:8192
    ds_read_b64_tr_b16 v[134:135], v13 offset:10240
    buffer_load_dwordx4 v[40:43], v16, s[24:27], s6 offen sc1
    buffer_load_dword v62, v17, s[24:27], s13 offen sc1
    ds_read_b64_tr_b16 v[152:153], v14 offset:12288
    ds_read_b64_tr_b16 v[154:155], v14 offset:14336
    ds_read_b64_tr_b16 v[156:157], v15 offset:12288
    ds_read_b64_tr_b16 v[158:159], v15 offset:14336
    ds_read_b64_tr_b16 v[144:145], v12 offset:12288
    ds_read_b64_tr_b16 v[146:147], v12 offset:14336
    ds_read_b64_tr_b16 v[148:149], v13 offset:12288
    ds_read_b64_tr_b16 v[150:151], v13 offset:14336
    s_mov_b32 s40, 0
    s_waitcnt vmcnt(4)
    v_alignbit_b32 v24, v34, v34, 7
    v_bitop3_b32 v24, v32, v33, v24 bitop3:0x96
    v_bitop3_b32 v24, v24, v35, v60 bitop3:0x96
    v_cmp_ne_u32 vcc, s46, v24
L_h0:
    s_cbranch_vccnz L_hf0
L_hgo0:
    s_waitcnt lgkmcnt(14)
    v_mfma_f32_16x16x32_bf16 v[216:219], v[104:107], v[32:35], 0
    buffer_load_dwordx4 v[44:47], v16, s[24:27], s7 offen sc1
    buffer_load_dword v63, v17, s[24:27], s14 offen sc1
    ds_read_b64_tr_b16 v[168:169], v14 offset:16384
    ds_read_b64_tr_b16 v[170:171], v14 offset:18432
    v_mfma_f32_16x16x32_bf16 v[220:223], v[108:111], v[32:35], 0
    ds_read_b64_tr_b16 v[172:173], v15 offset:16384
    ds_read_b64_tr_b16 v[174:175], v15 offset:18432
    ds_read_b64_tr_b16 v[160:161], v12 offset:16384
    v_mfma_f32_16x16x32_bf16 v[208:211], v[96:99], v[32:35], 0
    ds_read_b64_tr_b16 v[162:163], v12 offset:18432
    ds_read_b64_tr_b16 v[164:165], v13 offset:16384
    ds_read_b64_tr_b16 v[166:167], v13 offset:18432
    s_waitcnt vmcnt(4)
    v_alignbit_b32 v24, v38, v38, 7
    v_bitop3_b32 v24, v36, v37, v24 bitop3:0x96
    v_mfma_f32_16x16x32_bf16 v[212:215], v[100:103], v[32:35], 0
    v_bitop3_b32 v24, v24, v39, v61 bitop3:0x96
    v_cmp_ne_u32 vcc, s46, v24
    s_nop 0
L_h1:
    s_cbranch_vccnz L_hf1
L_hgo1:
    s_waitcnt lgkmcnt(14)
    v_mfma_f32_16x16x32_bf16 v[216:219], v[120:123], v[36:39], v[216:219]
    buffer_load_dwordx4 v[48:51], v16, s[24:27], s8 offen sc1
    buffer_load_dword v64, v17, s[24:27], s15 offen sc1
    ds_read_b64_tr_b16 v[184:185], v14 offset:20480
    ds_read_b64_tr_b16 v[186:187], v14 offset:22528
    v_mfma_f32_16x16x32_bf16 v[220:223], v[124:127], v[36:39], v[220:223]
    ds_read_b64_tr_b16 v[188:189], v15 offset:20480
    ds_read_b64_tr_b16 v[190:191], v15 offset:22528
    ds_read_b64_tr_b16 v[176:177], v12 offset:20480
    v_mfma_f32_16x16x32_bf16 v[208:211], v[112:115], v[36:39], v[208:211]
    ds_read_b64_tr_b16 v[178:179], v12 offset:22528
    ds_read_b64_tr_b16 v[180:181], v13 offset:20480
    ds_read_b64_tr_b16 v[182:183], v13 offset:22528
    s_waitcnt vmcnt(4)
    v_alignbit_b32 v24, v42, v42, 7
    v_bitop3_b32 v24, v40, v41, v24 bitop3:0x96
    v_mfma_f32_16x16x32_bf16 v[212:215], v[116:119], v[36:39], v[212:215]
    v_bitop3_b32 v24, v24, v43, v62 bitop3:0x96
    v_cmp_ne_u32 vcc, s46, v24
    s_nop 0
L_h2:
    s_cbranch_vccnz L_hf2
L_hgo2:
    s_waitcnt lgkmcnt(14)
    v_mfma_f32_16x16x32_bf16 v[216:219], v[136:139], v[40:43], v[216:219]
    buffer_load_dwordx4 v[52:55], v16, s[24:27], s9 offen sc1
    buffer_load_dword v65, v17, s[24:27], s50 offen sc1
    ds_read_b64_tr_b16 v[200:201], v14 offset:24576
    ds_read_b64_tr_b16 v[202:203], v14 offset:26624
    v_mfma_f32_16x16x32_bf16 v[220:223], v[140:143], v[40:43], v[220:223]
    ds_read_b64_tr_b16 v[204:205], v15 offset:24576
    ds_read_b64_tr_b16 v[206:207], v15 offset:26624
    ds_read_b64_tr_b16 v[192:193], v12 offset:24576
    v_mfma_f32_16x16x32_bf16 v[208:211], v[128:131], v[40:43], v[208:211]
    ds_read_b64_tr_b16 v[194:195], v12 offset:26624
    ds_read_b64_tr_b16 v[196:197], v13 offset:24576
    ds_read_b64_tr_b16 v[198:199], v13 offset:26624
    s_waitcnt vmcnt(4)
    v_alignbit_b32 v24, v46, v46, 7
    v_bitop3_b32 v24, v44, v45, v24 bitop3:0x96
    v_mfma_f32_16x16x32_bf16 v[212:215], v[132:135], v[40:43], v[212:215]
    v_bitop3_b32 v24, v24, v47, v63 bitop3:0x96
    v_cmp_ne_u32 vcc, s46, v24
    s_nop 0
L_h3:
    s_cbranch_vccnz L_hf3
L_hgo3:
    s_waitcnt lgkmcnt(14)
    v_mfma_f32_16x16x32_bf16 v[216:219], v[152:155], v[44:47], v[216:219]
    buffer_load_dwordx4 v[56:59], v16, s[24:27], s10 offen sc1
    buffer_load_dword v66, v17, s[24:27], s51 offen sc1
    v_mfma_f32_16x16x32_bf16 v[220:223], v[156:159], v[44:47], v[220:223]
    v_mfma_f32_16x16x32_bf16 v[208:211], v[144:147], v[44:47], v[208:211]
    s_waitcnt vmcnt(4)
    v_alignbit_b32 v24, v50, v50, 7
    v_bitop3_b32 v24, v48, v49, v24 bitop3:0x96
    v_mfma_f32_16x16x32_bf16 v[212:215], v[148:151], v[44:47], v[212:215]
    v_bitop3_b32 v24, v24, v51, v64 bitop3:0x96
    v_cmp_ne_u32 vcc, s46, v24
    s_nop 0
L_h4:
    s_cbranch_vccnz L_hf4
L_hgo4:
    s_waitcnt lgkmcnt(14)
    v_mfma_f32_16x16x32_bf16 v[216:219], v[168:171], v[48:51], v[216:219]
    v_mfma_f32_16x16x32_bf16 v[220:223], v[172:175], v[48:51], v[220:223]
    v_mfma_f32_16x16x32_bf16 v[208:211], v[160:163], v[48:51], v[208:211]
    s_waitcnt vmcnt(2)
    v_alignbit_b32 v24, v54, v54, 7
    v_bitop3_b32 v24, v52, v53, v24 bitop3:0x96
    v_mfma_f32_16x16x32_bf16 v[212:215], v[164:167], v[48:51], v[212:215]
    v_bitop3_b32 v24, v24, v55, v65 bitop3:0x96
    v_cmp_ne_u32 vcc, s46, v24
    s_nop 0
L_h5:
    s_cbranch_vccnz L_hf5
L_hgo5:
    s_waitcnt lgkmcnt(8)
    v_mfma_f32_16x16x32_bf16 v[216:219], v[184:187], v[52:55], v[216:219]
    s_waitcnt vmcnt(0)
    v_alignbit_b32 v24, v58, v58, 7
    v_bitop3_b32 v24, v56, v57, v24 bitop3:0x96
    v_mfma_f32_16x16x32_bf16 v[220:223], v[188:191], v[52:55], v[220:223]
    v_bitop3_b32 v24, v24, v59, v66 bitop3:0x96
    v_cmp_ne_u32 vcc, s46, v24
    s_nop 0
L_h6:
    s_cbranch_vccnz L_hf6
L_hgo6:
    s_waitcnt lgkmcnt(0)
    v_mfma_f32_16x16x32_bf16 v[216:219], v[200:203], v[56:59], v[216:219]
    v_mfma_f32_16x16x32_bf16 v[220:223], v[204:207], v[56:59], v[220:223]
    s_nop 6
    ds_write_b128 v232, v[216:219]
    ds_write_b128 v232, v[220:223] offset:1024
    v_mfma_f32_16x16x32_bf16 v[208:211], v[176:179], v[52:55], v[208:211]
    v_mfma_f32_16x16x32_bf16 v[212:215], v[180:183], v[52:55], v[212:215]
    v_mfma_f32_16x16x32_bf16 v[208:211], v[192:195], v[56:59], v[208:211]
    v_mfma_f32_16x16x32_bf16 v[212:215], v[196:199], v[56:59], v[212:215]
    s_waitcnt lgkmcnt(0)
    s_barrier
    ds_read_b128 v[24:27], v233
    ds_read_b128 v[28:31], v233 offset:1024
    s_nop 1
    s_waitcnt lgkmcnt(1)
    v_pk_add_f32 v[24:25], v[24:25], v[208:209]
    v_pk_add_f32 v[26:27], v[26:27], v[210:211]
    v_bfi_b32 v24, v234, s56, v24
    v_bfi_b32 v25, v234, s57, v25
    v_bfi_b32 v26, v234, s58, v26
    v_bfi_b32 v27, v234, s59, v27
    buffer_store_dwordx4 v[24:27], v237, s[24:27], s53 offen sc1
    s_waitcnt lgkmcnt(0)
    v_pk_add_f32 v[28:29], v[28:29], v[212:213]
    v_pk_add_f32 v[30:31], v[30:31], v[214:215]
    v_bfi_b32 v28, v234, s56, v28
    v_bfi_b32 v29, v234, s57, v29
    v_bfi_b32 v30, v234, s58, v30
    v_bfi_b32 v31, v234, s59, v31
    buffer_store_dwordx4 v[28:31], v237, s[24:27], s53 offen offset:256 sc1
    s_cmp_lg_u32 s18, 3
    s_cbranch_scc1 L_nomark
    v_mov_b32 v21, s46
    s_mov_b64 exec, 1
    buffer_store_dword v21, v17, s[24:27], s63 offen
    s_mov_b64 exec, -1
L_nomark:
    s_mov_b32 s40, 0
    s_waitcnt vmcnt(0)
L_rpoll:
    buffer_load_dwordx4 v[32:35], v238, s[24:27], s61 offen sc1
    buffer_load_dwordx4 v[36:39], v238, s[24:27], s62 offen sc1
    s_add_u32 s40, s40, 1
    s_waitcnt vmcnt(1)
    v_xor_b32 v32, s56, v32
    v_xor_b32 v33, s57, v33
    v_xor_b32 v34, s58, v34
    v_xor_b32 v35, s59, v35
    v_or3_b32 v21, v32, v33, v34
    s_waitcnt vmcnt(0)
    v_xor_b32 v36, s56, v36
    v_xor_b32 v37, s57, v37
    v_xor_b32 v38, s58, v38
    v_xor_b32 v39, s59, v39
    v_or3_b32 v21, v35, v36, v21
    v_or3_b32 v21, v37, v38, v21
    v_pk_add_f32 v[32:33], v[32:33], v[36:37]
    v_pk_add_f32 v[34:35], v[34:35], v[38:39]
    v_or_b32 v21, v39, v21
    v_and_b32 v21, 0xff, v21
    v_permlane32_swap_b32 v32, v34
    v_permlane32_swap_b32 v33, v35
    v_cmp_ne_u32 vcc, 0, v21
    v_add_f32 v32, v32, v34
    v_add_f32 v33, v33, v35
    s_cbranch_vccnz L_rfail
L_rdone:
    s_nop 0
    v_permlane16_swap_b32 v32, v33
    v_add_f32 v32, v32, v33
    v_cvt_pk_bf16_f32 v32, v32, v32
    buffer_store_short v32, v235, s[32:35], s55 offen
L_fin:
    s_cmp_eq_u32 s49, 0
    s_mov_b32 s37, 0
    s_cbranch_scc1 L_exit
    s_mov_b64 exec, 0xffff
L_apoll:
    buffer_load_dword v21, v17, s[24:27], s49 offen sc1
    s_add_u32 s37, s37, 1
    s_waitcnt vmcnt(0)
    v_cmp_ne_u32 vcc, s46, v21
    s_cmp_lt_u32 s37, 24
    s_cbranch_vccz L_adone
    s_cbranch_scc1 L_apoll
    buffer_wbl2 sc1
    s_waitcnt vmcnt(0)
L_adone:
    s_mov_b64 exec, -1
L_exit:
L_end:
    s_endpgm
L_helper_compute:
    s_barrier
    s_cmp_lg_u32 s18, 0
    s_cbranch_scc1 L_nopre
    s_cmp_ge_u32 s20, 16
    s_cbranch_scc1 L_nopre
    v_lshlrev_b32 v20, 7, v0
    s_lshl_b32 s3, s19, 4
    s_add_u32 s3, s3, s20
    s_mul_i32 s40, s3, 3584
    s_mul_i32 s3, s3, 896
    s_add_u32 s3, s3, 520704
    v_mov_b32 v21, s40
    v_mov_b32 v22, s3
    v_cmp_gt_u32 vcc, 28, v0
    s_lshl_b32 s3, s19, 1
    s_and_b32 s40, s20, 1
    v_cndmask_b32 v21, v22, v21, vcc
    v_add_u32 v20, v20, v21
    s_add_u32 s3, s3, s40
    s_lshl_b32 s3, s3, 7
    s_add_u32 s3, s3, 0xa0000
    s_mov_b32 exec_hi, 15
    v_writelane_b32 v20, s3, 35
    buffer_load_dword v21, v20, s[24:27], 0 offen sc1
    s_mov_b64 exec, -1
L_nopre:
    s_mov_b64 exec, 1
    buffer_load_dword v18, v17, s[28:31], 0 offen sc1
    s_mov_b64 exec, -1
    s_waitcnt vmcnt(0)
    v_readfirstlane_b32 s46, v18
    s_cmp_eq_u32 s46, 0
    s_cbranch_scc1 L_tagslowH
L_tagokH:
    s_mul_i32 s46, s46, 0x9e3779b1
    s_and_b32 s56, s46, 0xff
    s_bfe_u32 s57, s46, 0x80008
    s_bfe_u32 s58, s46, 0x80010
    s_lshr_b32 s59, s46, 24
    s_branch L_join
L_rfail:
    s_cmp_gt_u32 s40, 100000
    s_cbranch_scc1 L_rdone
    s_cmp_lt_u32 s40, 24
    s_cbranch_scc1 L_rpoll
    s_and_b32 s3, s40, 3
    s_cmp_lg_u32 s3, 0
    s_cbranch_scc1 L_rpoll
    buffer_wbl2 sc1
    s_waitcnt vmcnt(0)
    s_branch L_rpoll
L_hf0:
    s_add_u32 s40, s40, 1
    s_cmp_gt_u32 s40, 100000
    s_cbranch_scc1 L_hgo0
    s_waitcnt vmcnt(0)
    s_cmp_lt_u32 s40, 24
    s_cbranch_scc1 L_hr0
    s_and_b32 s3, s40, 3
    s_cmp_lg_u32 s3, 0
    s_cbranch_scc1 L_hr0
    buffer_wbl2 sc1
    s_waitcnt vmcnt(0)
    buffer_inv sc1
    s_waitcnt vmcnt(0)
L_hr0:
    buffer_load_dwordx4 v[32:35], v16, s[24:27], s4 offen sc1
    buffer_load_dword v60, v17, s[24:27], s11 offen sc1
    buffer_load_dwordx4 v[36:39], v16, s[24:27], s5 offen sc1
    buffer_load_dword v61, v17, s[24:27], s12 offen sc1
    buffer_load_dwordx4 v[40:43], v16, s[24:27], s6 offen sc1
    buffer_load_dword v62, v17, s[24:27], s13 offen sc1
    s_waitcnt vmcnt(4)
    v_alignbit_b32 v24, v34, v34, 7
    v_bitop3_b32 v24, v32, v33, v24 bitop3:0x96
    v_bitop3_b32 v24, v24, v35, v60 bitop3:0x96
    v_cmp_ne_u32 vcc, s46, v24
    s_nop 1
    s_cbranch_vccnz L_hf0
    s_branch L_hgo0
L_hf1:
    s_add_u32 s40, s40, 1
    s_cmp_gt_u32 s40, 100000
    s_cbranch_scc1 L_hgo1
    s_waitcnt vmcnt(0)
    s_cmp_lt_u32 s40, 24
    s_cbranch_scc1 L_hr1
    s_and_b32 s3, s40, 3
    s_cmp_lg_u32 s3, 0
    s_cbranch_scc1 L_hr1
    buffer_wbl2 sc1
    s_waitcnt vmcnt(0)
    buffer_inv sc1
    s_waitcnt vmcnt(0)
L_hr1:
    buffer_load_dwordx4 v[36:39], v16, s[24:27], s5 offen sc1
    buffer_load_dword v61, v17, s[24:27], s12 offen sc1
    buffer_load_dwordx4 v[40:43], v16, s[24:27], s6 offen sc1
    buffer_load_dword v62, v17, s[24:27], s13 offen sc1
    buffer_load_dwordx4 v[44:47], v16, s[24:27], s7 offen sc1
    buffer_load_dword v63, v17, s[24:27], s14 offen sc1
    s_waitcnt vmcnt(4)
    v_alignbit_b32 v24, v38, v38, 7
    v_bitop3_b32 v24, v36, v37, v24 bitop3:0x96
    v_bitop3_b32 v24, v24, v39, v61 bitop3:0x96
    v_cmp_ne_u32 vcc, s46, v24
    s_nop 1
    s_cbranch_vccnz L_hf1
    s_branch L_hgo1
L_hf2:
    s_add_u32 s40, s40, 1
    s_cmp_gt_u32 s40, 100000
    s_cbranch_scc1 L_hgo2
    s_waitcnt vmcnt(0)
    s_cmp_lt_u32 s40, 24
    s_cbranch_scc1 L_hr2
    s_and_b32 s3, s40, 3
    s_cmp_lg_u32 s3, 0
    s_cbranch_scc1 L_hr2
    buffer_wbl2 sc1
    s_waitcnt vmcnt(0)
    buffer_inv sc1
    s_waitcnt vmcnt(0)
L_hr2:
    buffer_load_dwordx4 v[40:43], v16, s[24:27], s6 offen sc1
    buffer_load_dword v62, v17, s[24:27], s13 offen sc1
    buffer_load_dwordx4 v[44:47], v16, s[24:27], s7 offen sc1
    buffer_load_dword v63, v17, s[24:27], s14 offen sc1
    buffer_load_dwordx4 v[48:51], v16, s[24:27], s8 offen sc1
    buffer_load_dword v64, v17, s[24:27], s15 offen sc1
    s_waitcnt vmcnt(4)
    v_alignbit_b32 v24, v42, v42, 7
    v_bitop3_b32 v24, v40, v41, v24 bitop3:0x96
    v_bitop3_b32 v24, v24, v43, v62 bitop3:0x96
    v_cmp_ne_u32 vcc, s46, v24
    s_nop 1
    s_cbranch_vccnz L_hf2
    s_branch L_hgo2
L_hf3:
    s_add_u32 s40, s40, 1
    s_cmp_gt_u32 s40, 100000
    s_cbranch_scc1 L_hgo3
    s_waitcnt vmcnt(0)
    s_cmp_lt_u32 s40, 24
    s_cbranch_scc1 L_hr3
    s_and_b32 s3, s40, 3
    s_cmp_lg_u32 s3, 0
    s_cbranch_scc1 L_hr3
    buffer_wbl2 sc1
    s_waitcnt vmcnt(0)
    buffer_inv sc1
    s_waitcnt vmcnt(0)
L_hr3:
    buffer_load_dwordx4 v[44:47], v16, s[24:27], s7 offen sc1
    buffer_load_dword v63, v17, s[24:27], s14 offen sc1
    buffer_load_dwordx4 v[48:51], v16, s[24:27], s8 offen sc1
    buffer_load_dword v64, v17, s[24:27], s15 offen sc1
    buffer_load_dwordx4 v[52:55], v16, s[24:27], s9 offen sc1
    buffer_load_dword v65, v17, s[24:27], s50 offen sc1
    s_waitcnt vmcnt(4)
    v_alignbit_b32 v24, v46, v46, 7
    v_bitop3_b32 v24, v44, v45, v24 bitop3:0x96
    v_bitop3_b32 v24, v24, v47, v63 bitop3:0x96
    v_cmp_ne_u32 vcc, s46, v24
    s_nop 1
    s_cbranch_vccnz L_hf3
    s_branch L_hgo3
L_hf4:
    s_add_u32 s40, s40, 1
    s_cmp_gt_u32 s40, 100000
    s_cbranch_scc1 L_hgo4
    s_waitcnt vmcnt(0)
    s_cmp_lt_u32 s40, 24
    s_cbranch_scc1 L_hr4
    s_and_b32 s3, s40, 3
    s_cmp_lg_u32 s3, 0
    s_cbranch_scc1 L_hr4
    buffer_wbl2 sc1
    s_waitcnt vmcnt(0)
    buffer_inv sc1
    s_waitcnt vmcnt(0)
L_hr4:
    buffer_load_dwordx4 v[48:51], v16, s[24:27], s8 offen sc1
    buffer_load_dword v64, v17, s[24:27], s15 offen sc1
    buffer_load_dwordx4 v[52:55], v16, s[24:27], s9 offen sc1
    buffer_load_dword v65, v17, s[24:27], s50 offen sc1
    buffer_load_dwordx4 v[56:59], v16, s[24:27], s10 offen sc1
    buffer_load_dword v66, v17, s[24:27], s51 offen sc1
    s_waitcnt vmcnt(4)
    v_alignbit_b32 v24, v50, v50, 7
    v_bitop3_b32 v24, v48, v49, v24 bitop3:0x96
    v_bitop3_b32 v24, v24, v51, v64 bitop3:0x96
    v_cmp_ne_u32 vcc, s46, v24
    s_nop 1
    s_cbranch_vccnz L_hf4
    s_branch L_hgo4
L_hf5:
    s_add_u32 s40, s40, 1
    s_cmp_gt_u32 s40, 100000
    s_cbranch_scc1 L_hgo5
    s_waitcnt vmcnt(0)
    s_cmp_lt_u32 s40, 24
    s_cbranch_scc1 L_hr5
    s_and_b32 s3, s40, 3
    s_cmp_lg_u32 s3, 0
    s_cbranch_scc1 L_hr5
    buffer_wbl2 sc1
    s_waitcnt vmcnt(0)
    buffer_inv sc1
    s_waitcnt vmcnt(0)
L_hr5:
    buffer_load_dwordx4 v[52:55], v16, s[24:27], s9 offen sc1
    buffer_load_dword v65, v17, s[24:27], s50 offen sc1
    buffer_load_dwordx4 v[56:59], v16, s[24:27], s10 offen sc1
    buffer_load_dword v66, v17, s[24:27], s51 offen sc1
    s_waitcnt vmcnt(2)
    v_alignbit_b32 v24, v54, v54, 7
    v_bitop3_b32 v24, v52, v53, v24 bitop3:0x96
    v_bitop3_b32 v24, v24, v55, v65 bitop3:0x96
    v_cmp_ne_u32 vcc, s46, v24
    s_nop 1
    s_cbranch_vccnz L_hf5
    s_branch L_hgo5
L_hf6:
    s_add_u32 s40, s40, 1
    s_cmp_gt_u32 s40, 100000
    s_cbranch_scc1 L_hgo6
    s_waitcnt vmcnt(0)
    s_cmp_lt_u32 s40, 24
    s_cbranch_scc1 L_hr6
    s_and_b32 s3, s40, 3
    s_cmp_lg_u32 s3, 0
    s_cbranch_scc1 L_hr6
    buffer_wbl2 sc1
    s_waitcnt vmcnt(0)
    buffer_inv sc1
    s_waitcnt vmcnt(0)
L_hr6:
    buffer_load_dwordx4 v[56:59], v16, s[24:27], s10 offen sc1
    buffer_load_dword v66, v17, s[24:27], s51 offen sc1
    s_waitcnt vmcnt(0)
    v_alignbit_b32 v24, v58, v58, 7
    v_bitop3_b32 v24, v56, v57, v24 bitop3:0x96
    v_bitop3_b32 v24, v24, v59, v66 bitop3:0x96
    v_cmp_ne_u32 vcc, s46, v24
    s_nop 1
    s_cbranch_vccnz L_hf6
    s_branch L_hgo6
L_tagslowW:
    s_mov_b32 s3, 0
    s_mov_b64 exec, 1
L_tagloopW:
    buffer_load_dword v18, v17, s[28:31], 0 offen sc1
    s_add_u32 s3, s3, 1
    s_waitcnt vmcnt(0)
    v_readfirstlane_b32 s46, v18
    s_cmp_gt_u32 s3, 100000
    s_cbranch_scc1 L_tagoutW
    s_cmp_eq_u32 s46, 0
    s_cbranch_scc1 L_tagloopW
L_tagoutW:
    s_mov_b64 exec, -1
    s_branch L_tagokW
L_tagslowH:
    s_mov_b32 s3, 0
    s_mov_b64 exec, 1
L_tagloopH:
    buffer_load_dword v18, v17, s[28:31], 0 offen sc1
    s_add_u32 s3, s3, 1
    s_waitcnt vmcnt(0)
    v_readfirstlane_b32 s46, v18
    s_cmp_gt_u32 s3, 100000
    s_cbranch_scc1 L_tagoutH
    s_cmp_eq_u32 s46, 0
    s_cbranch_scc1 L_tagloopH
L_tagoutH:
    s_mov_b64 exec, -1
    s_branch L_tagokH
L_tail:
    s_endpgm
.section .rodata,"a"
.p2align 6
.amdhsa_kernel standalone__swiglu_ffn__sampling_kernel
  .amdhsa_next_free_vgpr 240
  .amdhsa_next_free_sgpr 102
  .amdhsa_accum_offset 240
  .amdhsa_group_segment_fixed_size 0
  .amdhsa_kernarg_size 56
  .amdhsa_user_sgpr_count 2
  .amdhsa_user_sgpr_kernarg_segment_ptr 1
  .amdhsa_system_sgpr_workgroup_id_x 1
  .amdhsa_float_denorm_mode_32 3
.end_amdhsa_kernel
```
